```python
import torch

def _softmax(x, axis=-1):
    return torch.softmax(x, dim=axis)
def _gelu(x):
    return torch.nn.functional.gelu(x, approximate="tanh")
def _silu(x):
    return torch.nn.functional.silu(x)
def _sigmoid(x):
    return torch.sigmoid(x)
def _layernorm(x, axis=-1, eps=1e-5):
    m = x.mean(dim=axis, keepdim=True)
    v = x.var(dim=axis, keepdim=True, unbiased=False)
    return (x - m) / torch.sqrt(v + eps)
def _scatter_add(tgt, idx, src, axis=0):
    return tgt.clone().index_add_(axis, idx, src)
def _segment_sum(src, seg, n):
    out = torch.zeros((n,) + src.shape[1:], dtype=src.dtype)
    return out.index_add_(0, seg, src)
def _pad(x, pw):
    flat = tuple(v for pair in reversed(pw) for v in pair)
    return torch.nn.functional.pad(x, flat)

kernel_name = 'standalone__swiglu_ffn__decode'

def setup_inputs():

    _w = (lambda a: (lambda t: t.to(torch.bfloat16) if t.is_floating_point() else t)(torch.as_tensor(a)))
    B, S, D, F = 1, 1, 1024, 3584
    return {
        "x": _w((lambda *s: torch.randn(*s, dtype=torch.bfloat16) * 0.05)(B, S, D)),
        "w_gate": _w((lambda *s: torch.randn(*s, dtype=torch.bfloat16) * 0.05)(D, F)),
        "w_up": _w((lambda *s: torch.randn(*s, dtype=torch.bfloat16) * 0.05)(D, F)),
        "w_down": _w((lambda *s: torch.randn(*s, dtype=torch.bfloat16) * 0.05)(F, D)),
    }

def reference(x, w_gate, w_up, w_down):
    g = _silu(x @ w_gate)
    u = x @ w_up
    return (g * u) @ w_down
```

```asm
; @launch grid=(256,1,1) block=(448,1,1) lds=2816
.amdgcn_target "amdgcn-amd-amdhsa--gfx950"
.text
.globl standalone__swiglu_ffn__decode_kernel
.p2align 12
.p2align 8
.type standalone__swiglu_ffn__decode_kernel,@function
standalone__swiglu_ffn__decode_kernel:
  s_load_dwordx8 s[8:15], s[0:1], 0
  s_load_dwordx2 s[18:19], s[0:1], 48
  v_readfirstlane_b32 s24, v0
  s_cmp_ge_u32 s2, 224
  s_cbranch_scc1 L_cons
  s_cmpk_lt_u32 s24, 256
  s_cselect_b64 exec, -1, 0
  s_cbranch_execz L_t1
  s_and_b32 s20, s2, 7
  s_lshr_b32 s21, s2, 3
  v_and_b32 v5, 7, v0
  v_bfe_u32 v6, v0, 3, 3
  s_lshr_b32 s25, s24, 7
  s_add_u32 s22, s21, s25
  s_cmp_eq_u32 s22, 28
  s_cselect_b32 s22, 0, s22
  s_and_b32 s26, s24, 64
  v_and_b32 v3, 14, v0
  v_bfe_u32 v4, v0, 4, 2
  v_lshl_add_u32 v3, v3, 1, v4
  v_and_b32 v4, 1, v0
  v_lshl_add_u32 v3, v3, 1, v4
  s_mul_i32 s3, s20, 917504
  s_lshl_b32 s4, s22, 8
  s_add_u32 s3, s3, s4
  s_lshl_b32 s4, s26, 1
  s_add_u32 s3, s3, s4
  v_mul_u32_u24 v1, 7168, v6
  v_mul_u32_u24 v13, 37, v5
  v_lshlrev_b32 v5, 4, v5
  v_add3_u32 v1, v1, v5, s3
  s_lshl_b32 s35, s20, 8
  v_lshl_add_u32 v3, v3, 2, s35
  s_mov_b32 s6, 114688
  s_cmp_eq_u32 s25, 0
  s_waitcnt lgkmcnt(0)
  s_cselect_b64 s[10:11], s[10:11], s[12:13]
  global_load_dwordx4 v[32:35], v1, s[10:11] nt
  s_add_u32 s12, s10, 57344
  s_addc_u32 s13, s11, 0
  global_load_dword v8, v3, s[8:9]
  global_load_dwordx4 v[36:39], v1, s[12:13] nt
  v_add_u32 v1, s6, v1
  global_load_dwordx4 v[40:43], v1, s[10:11] nt
  global_load_dwordx4 v[44:47], v1, s[12:13] nt
  v_add_u32 v1, s6, v1
  global_load_dwordx4 v[48:51], v1, s[10:11] nt
  global_load_dwordx4 v[52:55], v1, s[12:13] nt
  v_add_u32 v1, s6, v1
  s_load_dword s23, s[18:19], 0
  s_lshl_b32 s3, s21, 1
  s_add_u32 s3, s3, s25
  s_lshl_b32 s3, s3, 10
  s_add_u32 s3, s3, s26
  s_lshl_b32 s3, s3, 7
  s_add_u32 s3, s3, s35
  s_addk_i32 s3, 4096
  v_and_b32 v19, 16, v0
  v_and_b32 v7, 32, v0
  v_lshl_add_u32 v2, v19, 4, v7
  v_and_b32 v16, 15, v0
  v_lshl_add_u32 v2, v2, 2, v16
  v_lshl_add_u32 v2, v2, 4, s3
  s_mov_b32 s7, 32768
  v_bfe_i32 v29, v0, 2, 1
  v_bfe_i32 v28, v0, 3, 1
  v_xor_b32 v28, 0xffff, v28
  v_and_b32 v29, v29, v28
  v_xor_b32 v28, v29, v28
  v_and_b32 v17, 3, v0
  v_mul_u32_u24 v4, 0x5555, v17
  v_lshlrev_b32 v12, 3, v17
  s_lshl_b32 s3, s22, 1
  s_add_u32 s3, s3, s25
  s_lshl_b32 s3, s3, 3
  s_add_u32 s3, s3, s20
  s_lshl_b32 s3, s3, 7
  s_add_u32 s3, s3, s26
  s_lshl_b32 s3, s3, 2
  s_addk_i32 s3, 4096
  v_lshl_add_u32 v20, v19, 3, v5
  v_add_u32 v20, s3, v20
  s_lshl_b32 s3, s21, 12
  s_add_u32 s3, s3, s24
  s_lshl_b32 s3, s3, 1
  s_addk_i32 s3, 6144
  v_lshl_add_u32 v21, v6, 9, v5
  v_add_u32 v21, s3, v21
  s_add_u32 s3, s20, 4
  s_lshl_b32 s3, s3, 7
  s_add_u32 s3, s3, s21
  s_lshl_b32 s3, s3, 8
  s_add_u32 s3, s3, s24
  s_lshl_b32 s3, s3, 1
  v_and_b32 v7, 24, v0
  v_lshl_add_u32 v22, v7, 11, v5
  v_add_u32 v22, s3, v22
  s_lshl_b32 s3, s20, 7
  v_lshl_add_u32 v7, v7, 2, s3
  s_getreg_b32 s33, hwreg(HW_REG_XCC_ID, 0, 4)
  s_movk_i32 s29, 0xff
  s_mov_b32 s30, 0x01010101
  v_mov_b32 v24, 0
  v_mov_b32 v25, 0
  v_mov_b32 v26, 0
  v_mov_b32 v27, 0
  s_waitcnt vmcnt(6)
  global_load_dwordx4 v[56:59], v1, s[10:11] nt
  s_waitcnt vmcnt(6)
  v_and_b32_dpp v16, v8, v28 row_newbcast:0 row_mask:0xf bank_mask:0xf
  v_and_b32_dpp v17, v8, v29 row_newbcast:0 row_mask:0xf bank_mask:0xf
  v_and_b32_dpp v18, v8, v28 row_newbcast:1 row_mask:0xf bank_mask:0xf
  v_and_b32_dpp v19, v8, v29 row_newbcast:1 row_mask:0xf bank_mask:0xf
  s_waitcnt vmcnt(5)
  global_load_dwordx4 v[60:63], v1, s[12:13] nt
  v_add_u32 v1, s6, v1
  global_load_dword v5, v7, s[18:19] offset:1024
  v_smfmac_f32_16x16x64_bf16 v[24:27], v[16:19], v[32:39], v4
  s_waitcnt vmcnt(6)
  global_load_dwordx4 v[64:67], v1, s[10:11] nt
  v_and_b32_dpp v16, v8, v28 row_newbcast:2 row_mask:0xf bank_mask:0xf
  v_and_b32_dpp v17, v8, v29 row_newbcast:2 row_mask:0xf bank_mask:0xf
  v_and_b32_dpp v18, v8, v28 row_newbcast:3 row_mask:0xf bank_mask:0xf
  v_and_b32_dpp v19, v8, v29 row_newbcast:3 row_mask:0xf bank_mask:0xf
  s_waitcnt vmcnt(6)
  global_load_dwordx4 v[68:71], v1, s[12:13] nt
  v_add_u32 v1, s6, v1
  v_smfmac_f32_16x16x64_bf16 v[24:27], v[16:19], v[40:47], v4
  s_waitcnt vmcnt(6)
  global_load_dwordx4 v[72:75], v1, s[10:11] nt
  v_and_b32_dpp v16, v8, v28 row_newbcast:4 row_mask:0xf bank_mask:0xf
  v_and_b32_dpp v17, v8, v29 row_newbcast:4 row_mask:0xf bank_mask:0xf
  v_and_b32_dpp v18, v8, v28 row_newbcast:5 row_mask:0xf bank_mask:0xf
  v_and_b32_dpp v19, v8, v29 row_newbcast:5 row_mask:0xf bank_mask:0xf
  s_waitcnt vmcnt(6)
  global_load_dwordx4 v[76:79], v1, s[12:13] nt
  v_add_u32 v1, s6, v1
  v_smfmac_f32_16x16x64_bf16 v[24:27], v[16:19], v[48:55], v4
  s_waitcnt vmcnt(6)
  global_load_dwordx4 v[80:83], v1, s[10:11] nt
  v_and_b32_dpp v16, v8, v28 row_newbcast:6 row_mask:0xf bank_mask:0xf
  v_and_b32_dpp v17, v8, v29 row_newbcast:6 row_mask:0xf bank_mask:0xf
  v_and_b32_dpp v18, v8, v28 row_newbcast:7 row_mask:0xf bank_mask:0xf
  v_and_b32_dpp v19, v8, v29 row_newbcast:7 row_mask:0xf bank_mask:0xf
  s_waitcnt vmcnt(6)
  global_load_dwordx4 v[84:87], v1, s[12:13] nt
  v_add_u32 v1, s6, v1
  v_smfmac_f32_16x16x64_bf16 v[24:27], v[16:19], v[56:63], v4
  s_waitcnt vmcnt(5)
  global_load_dwordx4 v[88:91], v1, s[10:11] nt
  v_and_b32_dpp v16, v8, v28 row_newbcast:8 row_mask:0xf bank_mask:0xf
  v_and_b32_dpp v17, v8, v29 row_newbcast:8 row_mask:0xf bank_mask:0xf
  v_and_b32_dpp v18, v8, v28 row_newbcast:9 row_mask:0xf bank_mask:0xf
  v_and_b32_dpp v19, v8, v29 row_newbcast:9 row_mask:0xf bank_mask:0xf
  s_waitcnt vmcnt(5)
  global_load_dwordx4 v[92:95], v1, s[12:13] nt
  v_smfmac_f32_16x16x64_bf16 v[24:27], v[16:19], v[64:71], v4
  s_waitcnt vmcnt(5)
  global_load_dwordx4 v[96:99], v2, s[14:15] offset:-4096 nt
  v_and_b32_dpp v16, v8, v28 row_newbcast:10 row_mask:0xf bank_mask:0xf
  v_and_b32_dpp v17, v8, v29 row_newbcast:10 row_mask:0xf bank_mask:0xf
  v_and_b32_dpp v18, v8, v28 row_newbcast:11 row_mask:0xf bank_mask:0xf
  v_and_b32_dpp v19, v8, v29 row_newbcast:11 row_mask:0xf bank_mask:0xf
  s_waitcnt vmcnt(5)
  global_load_dwordx4 v[100:103], v2, s[14:15] nt
  v_add_u32 v2, s7, v2
  v_smfmac_f32_16x16x64_bf16 v[24:27], v[16:19], v[72:79], v4
  s_waitcnt vmcnt(5)
  global_load_dwordx4 v[104:107], v2, s[14:15] offset:-4096 nt
  v_and_b32_dpp v16, v8, v28 row_newbcast:12 row_mask:0xf bank_mask:0xf
  v_and_b32_dpp v17, v8, v29 row_newbcast:12 row_mask:0xf bank_mask:0xf
  v_and_b32_dpp v18, v8, v28 row_newbcast:13 row_mask:0xf bank_mask:0xf
  v_and_b32_dpp v19, v8, v29 row_newbcast:13 row_mask:0xf bank_mask:0xf
  s_waitcnt vmcnt(5)
  global_load_dwordx4 v[108:111], v2, s[14:15] nt
  v_add_u32 v2, s7, v2
  v_smfmac_f32_16x16x64_bf16 v[24:27], v[16:19], v[80:87], v4
  v_and_b32_dpp v16, v8, v28 row_newbcast:14 row_mask:0xf bank_mask:0xf
  v_and_b32_dpp v17, v8, v29 row_newbcast:14 row_mask:0xf bank_mask:0xf
  v_and_b32_dpp v18, v8, v28 row_newbcast:15 row_mask:0xf bank_mask:0xf
  v_and_b32_dpp v19, v8, v29 row_newbcast:15 row_mask:0xf bank_mask:0xf
  s_waitcnt vmcnt(4)
  s_nop 0
  v_smfmac_f32_16x16x64_bf16 v[24:27], v[16:19], v[88:95], v4
L_t1:
  s_cbranch_execz L_t2
  s_waitcnt lgkmcnt(0)
  s_add_u32 s23, s23, 1
  s_mul_i32 s23, s23, s30
  v_lshrrev_b32 v23, v12, s23
  v_add_u32 v23, v23, v13
  v_and_b32 v23, s29, v23
  v_add_u32 v5, 1, v5
  v_lshl_or_b32 v3, v5, 4, s33
  v_permlane32_swap_b32 v24, v16
  v_permlane32_swap_b32 v25, v17
  v_permlane32_swap_b32 v26, v18
  v_permlane32_swap_b32 v27, v19
  v_add_f32_dpp v8, v16, v24 row_ror:8 row_mask:0xf bank_mask:0xf
  v_add_f32_dpp v9, v17, v25 row_ror:8 row_mask:0xf bank_mask:0xf
  v_add_f32_dpp v10, v18, v26 row_ror:8 row_mask:0xf bank_mask:0xf
  v_add_f32_dpp v11, v19, v27 row_ror:8 row_mask:0xf bank_mask:0xf
  s_mov_b64 exec, 0x00ff00ff
  v_bfi_b32 v8, s29, v23, v8
  global_store_dwordx4 v20, v[8:11], s[18:19] sc1
  s_mov_b64 exec, -1
  s_barrier
  global_load_dword v6, v7, s[18:19] offset:2048 sc1
  global_load_dwordx4 v[112:115], v2, s[14:15] offset:-4096 nt
  global_load_dwordx4 v[116:119], v2, s[14:15] nt
  v_add_u32 v2, s7, v2
  global_load_dwordx4 v[120:123], v2, s[14:15] offset:-4096 nt
  global_load_dwordx4 v[124:127], v2, s[14:15] nt
  v_mul_lo_u32 v5, v5, s30
  v_lshrrev_b32 v5, v12, v5
  v_add_u32 v5, v5, v13
  s_mov_b32 s5, 0x200000
  v_mov_b32 v24, 0
  v_mov_b32 v25, 0
  v_mov_b32 v26, 0
  v_mov_b32 v27, 0
  s_waitcnt vmcnt(3)
L_p1:
  global_load_dwordx4 v[32:35], v21, s[18:19] offset:-2048 sc1
  global_load_dwordx4 v[36:39], v21, s[18:19] offset:2048 sc1
  s_sub_u32 s5, s5, 1
  s_cbranch_scc1 L_end
  v_cmp_ne_u32 s[36:37], v3, v6
  s_waitcnt vmcnt(1)
  v_xor_b32 v32, v23, v32
  v_permlane32_swap_b32 v33, v35
  s_waitcnt vmcnt(0)
  v_xor_b32 v36, v23, v36
  v_bitop3_b32 v52, v32, v36, s29 bitop3:0xa8
  v_cmp_ne_u32 vcc, 0, v52
  v_permlane32_swap_b32 v32, v34
  v_pk_add_f32 v[48:49], v[32:33], v[34:35]
  s_cbranch_vccnz L_p1
  v_permlane32_swap_b32 v36, v38
  v_permlane16_swap_b32 v48, v49
  v_add_f32 v48, v48, v49
  v_permlane32_swap_b32 v37, v39
  v_pk_add_f32 v[50:51], v[36:37], v[38:39]
  v_add_f32_dpp v48, v48, v48 row_ror:8 row_mask:0xf bank_mask:0xf
  v_cvt_pk_bf16_f32 v48, 0, v48
  v_mul_f32 v56, 0xbfb8aa3b, v48
  v_exp_f32 v56, v56
  v_permlane16_swap_b32 v50, v51
  v_add_f32 v56, 1.0, v56
  v_rcp_f32 v56, v56
  v_add_f32 v50, v50, v51
  v_mul_f32 v49, v48, v56
  v_cvt_pk_bf16_f32 v49, 0, v49
  v_add_f32_dpp v50, v50, v50 row_ror:8 row_mask:0xf bank_mask:0xf
  v_cvt_pk_bf16_f32 v50, 0, v50
  v_mul_f32 v49, v50, v49
  v_cvt_pk_bf16_f32 v49, v49, v49
  s_cmp_lg_u64 s[36:37], 0
  s_nop 0
  v_and_b32_dpp v56, v49, v28 row_newbcast:0 row_mask:0xf bank_mask:0xf
  v_and_b32_dpp v57, v49, v29 row_newbcast:0 row_mask:0xf bank_mask:0xf
  v_and_b32_dpp v58, v49, v28 row_newbcast:1 row_mask:0xf bank_mask:0xf
  v_and_b32_dpp v59, v49, v29 row_newbcast:1 row_mask:0xf bank_mask:0xf
  v_and_b32_dpp v60, v49, v28 row_newbcast:2 row_mask:0xf bank_mask:0xf
  v_and_b32_dpp v61, v49, v29 row_newbcast:2 row_mask:0xf bank_mask:0xf
  v_smfmac_f32_16x16x64_bf16 v[24:27], v[56:59], v[96:103], v4
  v_and_b32_dpp v62, v49, v28 row_newbcast:3 row_mask:0xf bank_mask:0xf
  v_and_b32_dpp v63, v49, v29 row_newbcast:3 row_mask:0xf bank_mask:0xf
  v_and_b32_dpp v64, v49, v28 row_newbcast:4 row_mask:0xf bank_mask:0xf
  v_and_b32_dpp v65, v49, v29 row_newbcast:4 row_mask:0xf bank_mask:0xf
  v_smfmac_f32_16x16x64_bf16 v[24:27], v[60:63], v[104:111], v4
  v_and_b32_dpp v66, v49, v28 row_newbcast:5 row_mask:0xf bank_mask:0xf
  v_and_b32_dpp v67, v49, v29 row_newbcast:5 row_mask:0xf bank_mask:0xf
  v_and_b32_dpp v68, v49, v28 row_newbcast:6 row_mask:0xf bank_mask:0xf
  v_and_b32_dpp v69, v49, v29 row_newbcast:6 row_mask:0xf bank_mask:0xf
  v_smfmac_f32_16x16x64_bf16 v[24:27], v[64:67], v[112:119], v4
  v_and_b32_dpp v70, v49, v28 row_newbcast:7 row_mask:0xf bank_mask:0xf
  v_and_b32_dpp v71, v49, v29 row_newbcast:7 row_mask:0xf bank_mask:0xf
  s_nop 1
  v_smfmac_f32_16x16x64_bf16 v[24:27], v[68:71], v[120:127], v4
  s_mov_b32 exec_hi, 0
  s_cbranch_scc1 L_slow
  s_nop 5
  v_bfi_b32 v24, s29, v5, v24
  global_store_dwordx4 v22, v[24:27], s[18:19]
  s_endpgm
L_slow:
  s_nop 5
  v_bfi_b32 v24, s29, v5, v24
  global_store_dwordx4 v22, v[24:27], s[18:19] sc1
L_end:
L_t2:
  s_endpgm
.org standalone__swiglu_ffn__decode_kernel + 2176
L_cons:
  s_cmpk_ge_u32 s2, 256
  s_cbranch_scc1 L_end
  s_load_dwordx2 s[16:17], s[0:1], 32
  s_and_b32 s27, s2, 7
  s_lshl_b32 s20, s27, 5
  s_and_b32 s21, s2, 24
  s_add_u32 s20, s20, s21
  s_lshl_b32 s22, s20, 2
  s_add_u32 s25, s22, 1024
  v_and_b32 v3, 63, v0
  v_lshlrev_b32 v8, 2, v3
  v_mov_b32 v10, 0
  ds_write_b32 v8, v10 offset:2560
  s_waitcnt lgkmcnt(0)
  s_load_dword s23, s[18:19], s25
  s_load_dword s26, s[18:19], 0
  v_and_b32 v7, 31, v0
  v_mul_u32_u24 v9, 80, v7
  s_lshl_b32 s3, s27, 8
  s_and_b32 s4, s2, 8
  s_lshl_b32 s4, s4, 4
  s_add_u32 s3, s3, s4
  s_and_b32 s4, s2, 16
  s_lshr_b32 s4, s4, 1
  s_add_u32 s3, s3, s4
  v_and_b32 v14, 28, v0
  v_add_u32 v7, v7, v14
  v_lshl_add_u32 v7, v7, 1, s3
  s_lshl_b32 s4, s20, 11
  s_lshl_b32 s3, s24, 5
  s_add_u32 s4, s4, s3
  s_add_u32 s4, s4, 0x40000
  v_lshl_add_u32 v1, v3, 4, s4
  v_and_b32 v14, 7, v0
  v_mul_u32_u24 v17, 37, v14
  v_and_b32 v16, 3, v0
  v_lshlrev_b32 v16, 3, v16
  v_bfe_u32 v19, v0, 4, 2
  v_lshl_add_u32 v14, v14, 2, v19
  v_mul_u32_u24 v14, 80, v14
  v_bfe_u32 v19, v0, 3, 1
  v_lshl_add_u32 v14, v19, 2, v14
  s_lshr_b32 s4, s24, 3
  v_add_u32 v14, s4, v14
  s_getreg_b32 s33, hwreg(HW_REG_XCC_ID, 0, 4)
  s_movk_i32 s29, 0xff
  v_mov_b32 v4, s22
  v_mov_b32 v10, 1
  s_mov_b32 s5, 0x200000
  s_waitcnt lgkmcnt(0)
  s_add_u32 s23, s23, 1
  s_add_u32 s26, s26, 1
  s_lshl_b32 s4, s23, 4
  s_or_b32 s33, s33, s4
  v_mov_b32 v5, s33
  global_store_dword v4, v5, s[18:19] offset:2048
  v_mov_b32 v6, s23
  v_mov_b32 v11, s26
  s_mul_i32 s23, s23, 0x01010101
  v_lshrrev_b32 v2, v16, s23
  v_add_u32 v2, v2, v17
  v_and_b32 v2, s29, v2
  global_load_ushort v15, v7, s[16:17]
  s_barrier
L_p2:
  global_load_dwordx4 v[32:35], v1, s[18:19] sc1
  global_load_dwordx4 v[36:39], v1, s[18:19] offset:1024 sc1
  s_sub_u32 s5, s5, 1
  s_cbranch_scc1 L_end
  s_waitcnt vmcnt(0)
  v_xor_b32 v32, v2, v32
  v_xor_b32 v36, v2, v36
  v_bitop3_b32 v26, v32, v36, s29 bitop3:0xa8
  v_cmp_ne_u32 vcc, 0, v26
  v_pk_add_f32 v[22:23], v[36:37], v[32:33]
  v_pk_add_f32 v[24:25], v[38:39], v[34:35]
  s_cbranch_vccnz L_p2
  s_cmp_lg_u32 s20, 0
  v_permlane32_swap_b32 v22, v24
  v_permlane32_swap_b32 v23, v25
  v_pk_add_f32 v[22:23], v[22:23], v[24:25]
  s_nop 1
  v_permlane16_swap_b32 v22, v23
  v_add_f32 v30, v22, v23
  ds_write_b32 v14, v30
  s_mov_b32 exec_hi, 0
  ds_add_rtn_u32 v12, v8, v10 offset:2560
  ds_read_b128 v[64:67], v9
  ds_read_b128 v[68:71], v9 offset:16
  ds_read_b128 v[72:75], v9 offset:32
  ds_read_b64 v[76:77], v9 offset:48
  s_waitcnt lgkmcnt(4)
  v_cmpx_eq_u32 vcc, 6, v12
  s_cbranch_vccz L_fin
  s_waitcnt lgkmcnt(2)
  v_pk_add_f32 v[64:65], v[64:65], v[66:67]
  v_pk_add_f32 v[68:69], v[68:69], v[70:71]
  v_pk_add_f32 v[64:65], v[64:65], v[68:69]
  s_waitcnt lgkmcnt(0)
  v_pk_add_f32 v[72:73], v[72:73], v[74:75]
  v_pk_add_f32 v[64:65], v[64:65], v[76:77]
  v_pk_add_f32 v[64:65], v[64:65], v[72:73]
  v_add_f32 v64, v64, v65
  v_cvt_pk_bf16_f32 v13, v64, v64
  global_store_short v7, v13, s[16:17]
  global_store_dword v4, v6, s[18:19] offset:1024
  s_cbranch_scc1 L_fin
  global_store_dword v4, v11, s[18:19]
L_fin:
  s_endpgm
.section .rodata,"a"
.p2align 6
.amdhsa_kernel standalone__swiglu_ffn__decode_kernel
  .amdhsa_next_free_vgpr 128
  .amdhsa_next_free_sgpr 40
  .amdhsa_accum_offset 128
  .amdhsa_group_segment_fixed_size 0
  .amdhsa_kernarg_size 56
  .amdhsa_user_sgpr_count 2
  .amdhsa_user_sgpr_kernarg_segment_ptr 1
  .amdhsa_system_sgpr_workgroup_id_x 1
  .amdhsa_float_denorm_mode_32 3
.end_amdhsa_kernel
```
